```python
import torch

def _softmax(x, axis=-1):
    return torch.softmax(x, dim=axis)
def _gelu(x):
    return torch.nn.functional.gelu(x, approximate="tanh")
def _silu(x):
    return torch.nn.functional.silu(x)
def _sigmoid(x):
    return torch.sigmoid(x)
def _layernorm(x, axis=-1, eps=1e-5):
    m = x.mean(dim=axis, keepdim=True)
    v = x.var(dim=axis, keepdim=True, unbiased=False)
    return (x - m) / torch.sqrt(v + eps)
def _scatter_add(tgt, idx, src, axis=0):
    return tgt.clone().index_add_(axis, idx, src)
def _segment_sum(src, seg, n):
    out = torch.zeros((n,) + src.shape[1:], dtype=src.dtype)
    return out.index_add_(0, seg, src)
def _pad(x, pw):
    flat = tuple(v for pair in reversed(pw) for v in pair)
    return torch.nn.functional.pad(x, flat)

kernel_name = 'standalone__sliding_block_cached__decode'

def setup_inputs():

    _w = (lambda a: (lambda t: t.to(torch.bfloat16) if t.is_floating_point() else t)(torch.as_tensor(a)))
    B, Sq, D = 2, 1, 640
    Hq, Hkv, Sk, Dh = 32, 32, 16384, 128
    assert Hq % Hkv == 0, (Hq, Hkv)
    return {
        "x": _w((lambda *s: torch.randn(*s, dtype=torch.bfloat16) * 0.8)(B, Sq, D)),
        "k_cache": _w((lambda *s: torch.randn(*s, dtype=torch.bfloat16) * 0.8)(B, Hkv, Sk, Dh)),
        "v_cache": _w((lambda *s: torch.randn(*s, dtype=torch.bfloat16) * 0.05)(B, Hkv, Sk, Dh)),
        "wq": _w((lambda *s: torch.randn(*s, dtype=torch.bfloat16) * 0.8)(D, Hq * Dh) * (D ** -0.5)),
        "wo": _w((lambda *s: torch.randn(*s, dtype=torch.bfloat16) * 0.05)(Hq * Dh, D) * ((Hq * Dh) ** -0.5)),
    }

def reference(x, k_cache, v_cache, wq, wo):
    B, Sq, D = x.shape
    Hq, Dh = 32, 128
    Hkv, Sk = k_cache.shape[1], k_cache.shape[2]
    W = min(4096, max(256, Sk // 4))
    rep = Hq // Hkv
    q = (lambda x, *d: x.permute(*d))((x @ wq).reshape(B, Sq, Hq, Dh), 0, 2, 1, 3)
    k = (lambda x, n, axis: torch.repeat_interleave(x, n, dim=axis))(k_cache[:, :, Sk - W:, :], rep, axis=1)
    v = (lambda x, n, axis: torch.repeat_interleave(x, n, dim=axis))(v_cache[:, :, Sk - W:, :], rep, axis=1)
    scores = torch.einsum("bhqd,bhkd->bhqk", q, k) * (Dh ** -0.5)
    p = _softmax(scores, axis=-1)
    o = torch.einsum("bhqk,bhkd->bhqd", p, v)
    return (lambda x, *d: x.permute(*d))(o, 0, 2, 1, 3).reshape(B, Sq, Hq * Dh) @ wo
```

```asm
; @launch grid=(256,1,1) block=(512,1,1) lds=13568
.amdgcn_target "amdgcn-amd-amdhsa--gfx950"
.text
.globl standalone__sliding_block_cached__decode_kernel
.p2align 8
.type standalone__sliding_block_cached__decode_kernel,@function
standalone__sliding_block_cached__decode_kernel:
    s_load_dwordx16 s[4:19], s[0:1], 0
    s_cmpk_ge_u32 s2, 0x100
    s_cbranch_scc1 L_end
    s_getpc_b64 s[48:49]
L_pc:
    v_lshlrev_b32 v3, 5, v0
    v_min_u32 v3, L_end-L_pc, v3
    global_load_dword v3, v3, s[48:49]
    s_and_b32 s62, s2, 0x27
    s_lshr_b32 s59, s2, 6
    s_lshl3_add_u32 s21, s59, s62
    s_lshl2_add_u32 s62, s21, 3
    s_lshl_b32 s62, s62, 20
    v_and_b32 v43, 15, v0
    s_bitcmp1_b32 s2, 3
    s_cselect_b32 s60, 0xea300, 0
    s_bitcmp1_b32 s2, 4
    s_cselect_b32 s59, 0xf8300, 0
    s_xor_b32 s60, s59, s60
    v_lshl_add_u32 v2, v43, 4, s60
    v_bfe_i32 v68, v0, 4, 1
    v_and_b32 v68, 0x1a100, v68
    v_xor_b32 v2, v68, v2
    v_bfe_i32 v68, v0, 5, 1
    v_and_b32 v68, 0x68800, v68
    v_xor_b32 v2, v68, v2
    v_bfe_i32 v68, v0, 6, 1
    v_and_b32 v68, 0x53600, v68
    v_xor_b32 v2, v68, v2
    v_bfe_i32 v68, v0, 7, 1
    v_and_b32 v68, 0x10200, v68
    v_xor_b32 v2, v68, v2
    v_bfe_i32 v68, v0, 8, 1
    v_and_b32 v68, 0x5af00, v68
    v_xor_b32 v2, v68, v2
    s_mov_b32 s26, 0x100000
    s_mov_b32 s27, 0x20000
    v_lshrrev_b32 v45, 6, v0
    v_bfe_u32 v44, v0, 4, 2
    v_readfirstlane_b32 s20, v45
    v_lshlrev_b32 v64, 13, v44
    v_lshl_add_u32 v64, v43, 4, v64
    v_lshrrev_b32 v46, 3, v43
    v_mul_u32_u24 v46, 1280, v46
    v_lshl_add_u32 v65, v44, 1, v46
    s_mov_b32 s98, s2
    s_and_b32 s63, s98, 7
    s_mul_i32 s63, s63, 80
    s_mov_b32 s99, 10
    s_mul_i32 s59, s99, s20
    s_add_u32 s63, s63, s59
    s_lshl_b32 s59, s63, 13
    s_lshr_b32 s60, s98, 3
    s_lshl_b32 s60, s60, 8
    s_add_u32 s59, s59, s60
    s_lshl_b32 s34, s99, 13
    s_sub_i32 s34, s34, 7936
    s_mov_b32 s35, 0x20000
    v_lshl_add_u32 v65, s63, 1, v65
    s_mov_b32 s42, 2560
    s_mov_b32 s43, 0x20000
    s_waitcnt lgkmcnt(0)
    s_add_u32 s24, s6, s62
    s_addc_u32 s25, s7, 0
    buffer_load_dwordx4 v[112:115], v2, s[24:27], 0 offen nt
    v_xor_b32 v68, 0x53400, v2
    s_add_u32 s32, s10, s59
    s_addc_u32 s33, s11, 0
    s_mov_b32 s40, s4
    s_mov_b32 s41, s5
    s_and_b32 s52, s2, 7
    s_mul_i32 s52, s52, 655360
    s_add_u32 s52, s52, 0x140
    s_load_dword s55, s[10:11], s52
    s_load_dword s56, s[4:5], 0x80
    s_load_dword s53, s[18:19], 0
    s_and_b32 s52, s21, 31
    s_mul_i32 s52, s52, 163840
    s_add_u32 s52, s52, 0x100
    s_load_dword s57, s[12:13], s52
    buffer_load_dwordx4 v[72:75], v64, s[32:35], 0 offen nt
    v_add_u32 v64, 0x8000, v64
    s_barrier
    buffer_load_dwordx4 v[76:79], v64, s[32:35], 0 offen nt
    v_add_u32 v64, 0x8000, v64
    buffer_load_dwordx4 v[80:83], v64, s[32:35], 0 offen nt
    s_barrier
    buffer_load_dwordx4 v[116:119], v68, s[24:27], 0 offen nt
    v_xor_b32 v68, 0x5ac00, v2
    s_barrier
    buffer_load_dwordx4 v[120:123], v68, s[24:27], 0 offen nt
    v_xor_b32 v68, 0x9800, v2
    s_barrier
    buffer_load_dwordx4 v[124:127], v68, s[24:27], 0 offen nt
    v_xor_b32 v68, 0x9e500, v2
    buffer_load_dwordx4 v[128:131], v68, s[24:27], 0 offen nt
    v_xor_b32 v68, 0xcd100, v2
    s_barrier
    buffer_load_dwordx4 v[132:135], v68, s[24:27], 0 offen nt
    v_xor_b32 v68, 0xc4900, v2
    buffer_load_dwordx4 v[136:139], v68, s[24:27], 0 offen nt
    v_xor_b32 v68, 0x97d00, v2
    s_barrier
    buffer_load_ushort v32, v65, s[40:43], 0 offen offset:0
    buffer_load_ushort v33, v65, s[40:43], 0 offen offset:8
    buffer_load_ushort v34, v65, s[40:43], 0 offen offset:16
    buffer_load_dwordx4 v[140:143], v68, s[24:27], 0 offen nt
    v_xor_b32 v68, 0x68d00, v2
    v_and_b32 v1, 63, v0
    v_lshlrev_b32 v66, 4, v1
    s_and_b32 s21, s21, 31
    s_bfe_u32 s22, s2, 0x10005
    s_bfe_u32 s23, s2, 0x20003
    s_bfe_u32 s61, s2, 0x30003
    v_and_b32 v45, 1, v0
    v_lshlrev_b32 v45, 4, v45
    v_mov_b32 v46, 0xffff
    v_lshlrev_b32 v45, v45, v46
    v_bfe_u32 v46, v0, 1, 2
    v_cmp_eq_u32 vcc, 0, v46
    s_nop 1
    v_cndmask_b32 v4, 0, v45, vcc
    v_cmp_eq_u32 vcc, 1, v46
    s_nop 1
    v_cndmask_b32 v5, 0, v45, vcc
    v_cmp_eq_u32 vcc, 2, v46
    s_nop 1
    v_cndmask_b32 v6, 0, v45, vcc
    v_cmp_eq_u32 vcc, 3, v46
    s_nop 1
    v_cndmask_b32 v7, 0, v45, vcc
    s_add_u32 s28, s8, s62
    s_addc_u32 s29, s9, 0
    s_mov_b32 s44, s18
    s_mov_b32 s45, s19
    s_mov_b32 s30, 0x100000
    s_mov_b32 s31, 0x20000
    s_mov_b32 s46, 0x100000
    s_mov_b32 s47, 0x20000
    s_mov_b32 s64, 0xaaaaaaaa
    s_mov_b32 s65, 0xaaaaaaaa
    v_mov_b32 v61, 0x3ff
    v_bfe_u32 v45, v0, 2, 2
    v_and_b32 v46, 1, v0
    v_lshl_add_u32 v70, v45, 1, v46
    v_bfe_u32 v45, v0, 2, 1
    v_bfe_u32 v46, v0, 3, 1
    v_lshl_add_u32 v69, v45, 1, v46
    v_lshrrev_b32 v45, 4, v0
    v_bfe_u32 v46, v0, 1, 1
    v_lshl_add_u32 v58, v45, 1, v46
    v_mul_u32_u24 v63, 1088, v70
    v_lshl_add_u32 v63, v58, 4, v63
    s_mul_i32 s59, s20, 1088
    v_and_b32 v45, 32, v0
    v_lshl_add_u32 v45, v43, 1, v45
    v_bfe_u32 v46, v0, 4, 1
    v_add_u32 v45, v45, v46
    v_lshl_add_u32 v62, v45, 4, s59
    s_and_b32 s59, s98, 0xf8
    s_add_u32 s59, s59, s20
    s_and_b32 s60, s98, 7
    s_lshl3_add_u32 s59, s59, s60
    s_lshl_b32 s59, s59, 7
    s_add_u32 s59, s59, 65536
    v_and_b32 v45, 7, v58
    v_lshl_add_u32 v45, v45, 2, v69
    v_lshl_add_u32 v48, v45, 2, s59
    s_lshl1_add_u32 s59, s21, s22
    s_lshr_b32 s60, s20, 1
    s_lshl2_add_u32 s59, s59, s60
    s_and_b32 s60, s20, 1
    s_lshl4_add_u32 s59, s59, s60
    s_lshl_b32 s59, s59, 6
    s_add_u32 s59, s59, 65536
    v_lshl_add_u32 v45, v70, 3, v44
    v_lshl_add_u32 v49, v45, 4, s59
    v_lshrrev_b32 v45, 4, v0
    v_lshl_add_u32 v45, v45, 2, v69
    v_lshlrev_b32 v71, 1, v45
    s_waitcnt vmcnt(13)
    s_waitcnt vmcnt(9)
    s_waitcnt vmcnt(8)
    s_waitcnt vmcnt(7)
    s_waitcnt vmcnt(6)
    s_waitcnt vmcnt(5)
    buffer_load_dwordx4 v[144:147], v68, s[24:27], 0 offen nt
    v_xor_b32 v68, 0x3b900, v2
    s_barrier
    buffer_load_dwordx4 v[148:151], v68, s[24:27], 0 offen nt
    v_xor_b32 v68, 0x32100, v2
    s_barrier
    buffer_load_dwordx4 v[152:155], v68, s[24:27], 0 offen nt
    v_xor_b32 v68, 0x61500, v2
    s_barrier
    s_waitcnt vmcnt(7)
    buffer_load_dwordx4 v[156:159], v68, s[24:27], 0 offen nt
    v_xor_b32 v68, 0xf6800, v2
    s_barrier
    s_waitcnt vmcnt(4)
    v_sub_u32 v45, s99, v44
    v_lshl_or_b32 v32, v32, 16, v32
    v_lshl_or_b32 v33, v33, 16, v33
    v_lshl_or_b32 v34, v34, 16, v34
    v_cmp_lt_i32 vcc, 8, v45
    s_nop 1
    v_cndmask_b32 v34, 0, v34, vcc
    v_and_b32 v24, v32, v4
    v_and_b32 v25, v32, v5
    v_and_b32 v26, v32, v6
    v_and_b32 v27, v32, v7
    s_nop 1
    v_mfma_f32_16x16x32_bf16 v[12:15], v[24:27], v[72:75], 0
    v_and_b32 v28, v33, v4
    v_and_b32 v29, v33, v5
    v_and_b32 v30, v33, v6
    v_and_b32 v31, v33, v7
    s_nop 1
    v_mfma_f32_16x16x32_bf16 v[12:15], v[28:31], v[76:79], v[12:15]
    v_and_b32 v24, v34, v4
    v_and_b32 v25, v34, v5
    v_and_b32 v26, v34, v6
    v_and_b32 v27, v34, v7
    s_nop 1
    v_mfma_f32_16x16x32_bf16 v[12:15], v[24:27], v[80:83], v[12:15]
    s_waitcnt lgkmcnt(0)
    s_mov_b32 s58, 0x80000
    s_mul_i32 s53, s53, 0x9e3779b1
    s_add_u32 s53, s53, 0x7f4a7c15
    s_and_b32 s54, s53, 0x3ff
    s_and_b32 s59, s53, 1
    s_bfe_u32 s55, s53, 0x9000a
    s_lshl1_add_u32 s55, s55, s59
    s_bfe_u32 s56, s53, 0x90013
    s_lshl1_add_u32 s56, s56, s59
    ds_write_b128 v62, v[12:15] offset:4352
    v_mov_b32 v67, s55
    v_mov_b32 v45, s56
    v_cmp_lt_u32 vcc, 1, v69
    s_nop 1
    v_cndmask_b32 v67, v67, v45, vcc
    v_and_b32 v46, 1, v69
    v_mov_b32 v45, s54
    v_cmp_eq_u32 vcc, 1, v46
    s_nop 1
    v_cndmask_b32 v57, v45, v67, vcc
    s_waitcnt lgkmcnt(0)
    s_waitcnt vmcnt(3)
    buffer_load_dwordx4 v[160:163], v68, s[24:27], 0 offen nt
    v_xor_b32 v68, 0xa5c00, v2
    s_barrier
    ds_read_b128 v[72:75], v63 offset:4352
    s_waitcnt lgkmcnt(0)
    v_add_f32_dpp v45, v72, v72 row_ror:8 row_mask:0xf bank_mask:0x3
    v_add_f32_dpp v45, v73, v73 row_ror:8 row_mask:0xf bank_mask:0xc
    v_add_f32_dpp v46, v74, v74 row_ror:8 row_mask:0xf bank_mask:0x3
    v_add_f32_dpp v46, v75, v75 row_ror:8 row_mask:0xf bank_mask:0xc
    v_add_f32_dpp v76, v45, v45 row_shl:4 row_mask:0xf bank_mask:0x5
    s_nop 0
    v_add_f32_dpp v76, v46, v46 row_shr:4 row_mask:0xf bank_mask:0xa
    s_nop 1
    v_add_f32_dpp v76, v76, v76 quad_perm:[1,0,3,2] row_mask:0xf bank_mask:0xf
    v_add_u32 v76, 0x200, v76
    v_bfi_b32 v76, v61, v57, v76
    s_mov_b64 exec, s[64:65]
    buffer_store_dword v76, v48, s[44:47], 0 offen sc1
    s_mov_b64 exec, -1
    s_lshl_b32 s59, s21, 10
    s_add_u32 s59, s59, 4096
    s_lshl_b32 s60, s22, 9
    v_xor_b32 v45, s60, v66
    v_add_u32 v56, s59, v45
    s_lshl3_add_u32 s60, s61, s20
    s_lshl4_add_u32 s59, s60, s59
    v_mov_b32 v55, s59
    s_getreg_b32 s98, hwreg(HW_REG_XCC_ID, 0, 4)
    s_lshl4_add_u32 s98, s53, s98
    s_mov_b32 s57, 0x3fb8aa3b
    s_and_b32 s99, s53, 0x1ffff
    s_lshl_b32 s99, s99, 6
    s_or_b32 s99, s99, 0x4b000000
    s_mov_b32 s16, s61
    s_lshl_b32 s17, s16, 8
    s_lshl_b32 s18, s16, 13
    s_cmp_lt_u32 s16, 5
    s_cselect_b32 s38, 163840, 0
    s_mov_b32 s59, 524288
    v_lshrrev_b32 v45, 4, v0
    v_lshl_add_u32 v45, v45, 6, v43
    v_lshl_add_u32 v54, v45, 2, s59
    s_lshl3_add_u32 s59, s21, s61
    s_cmp_ge_u32 s59, 5
    s_cbranch_scc1 L_noinit
    v_mov_b32 v24, 0
    v_mov_b32 v25, s99
    s_not_b64 exec, s[64:65]
    buffer_store_dwordx2 v[24:25], v54, s[44:47], s18 offen sc1
    s_mov_b64 exec, -1
L_noinit:
    s_waitcnt vmcnt(3)
    buffer_load_dwordx4 v[164:167], v68, s[24:27], 0 offen nt
    v_xor_b32 v68, 0xac400, v2
    s_barrier
    s_mul_i32 s59, s21, 163840
    s_add_u32 s36, s12, s59
    s_addc_u32 s37, s13, 0
    s_mov_b32 s39, 0x20000
    s_mov_b32 s48, s14
    s_mov_b32 s49, s15
    s_mov_b32 s50, 2560
    s_mov_b32 s51, 0x20000
    s_mov_b32 s4, 0x11111111
    s_mov_b32 s5, 0x11111111
    v_and_b32 v45, 1, v44
    v_lshlrev_b32 v45, 4, v45
    v_lshl_add_u32 v45, v43, 5, v45
    s_mul_i32 s59, s20, 544
    v_add_u32 v50, s59, v45
    v_lshrrev_b32 v46, 4, v0
    v_mul_u32_u24 v51, 544, v70
    v_lshl_add_u32 v51, v46, 4, v51
    v_mul_u32_u24 v42, 5120, v46
    v_lshl_add_u32 v42, v43, 4, v42
    s_lshl3_add_u32 s59, s21, s20
    s_lshl_b32 s59, s59, 9
    s_add_u32 s59, s59, 393216
    v_lshl_add_u32 v53, v1, 3, s59
    s_lshl3_add_u32 s60, s22, s23
    s_lshl3_add_u32 s59, s60, s59
    v_and_b32 v45, 0x34, v0
    v_bfe_u32 v46, v0, 3, 1
    v_lshl_add_u32 v45, v45, 1, v46
    v_lshl_add_u32 v52, v45, 2, s59
    v_and_b32 v45, 31, v58
    v_lshl_add_u32 v45, v45, 2, v69
    s_lshr_b32 s60, s20, 2
    s_mul_i32 s60, s60, 1280
    v_lshl_add_u32 v58, v45, 1, s60
    s_waitcnt vmcnt(3)
    buffer_load_dwordx4 v[168:171], v68, s[24:27], 0 offen nt
    v_xor_b32 v68, 0xff000, v2
    s_barrier
    s_waitcnt vmcnt(3)
    buffer_load_dwordx4 v[172:175], v68, s[24:27], 0 offen nt
    v_xor_b32 v68, 0xa8600, v2
    s_barrier
    s_waitcnt vmcnt(3)
    buffer_load_dwordx4 v[80:83], v49, s[44:47], 0 offen sc1
    buffer_load_dwordx4 v[176:179], v68, s[24:27], 0 offen nt
    v_xor_b32 v68, 0xfb200, v2
    s_barrier
    s_waitcnt vmcnt(4)
    buffer_load_dwordx4 v[180:183], v68, s[24:27], 0 offen nt
    v_xor_b32 v68, 0xf2a00, v2
    s_barrier
    s_waitcnt vmcnt(4)
    buffer_load_dwordx4 v[184:187], v68, s[24:27], 0 offen nt
    v_xor_b32 v68, 0xa1e00, v2
    s_barrier
    s_waitcnt vmcnt(4)
    buffer_load_dwordx4 v[188:191], v68, s[24:27], 0 offen nt
    v_xor_b32 v68, 0x36300, v2
    s_barrier
    s_waitcnt vmcnt(3)
L_q_check:
    v_xor_b32 v80, s54, v80
    v_xor_b32 v81, s55, v81
    v_xor_b32 v82, s54, v82
    v_xor_b32 v83, s56, v83
    v_or3_b32 v45, v80, v81, v82
    v_bitop3_b32 v45, v45, v83, v61 bitop3:0xa8
    v_cmp_ne_u32 vcc, 0, v45
    s_cbranch_vccnz L_q_retry
L_q_ok:
    v_add_f32_dpp v45, v80, v80 row_ror:8 row_mask:0xf bank_mask:0x3
    v_add_f32_dpp v45, v81, v81 row_ror:8 row_mask:0xf bank_mask:0xc
    v_add_f32_dpp v46, v82, v82 row_ror:8 row_mask:0xf bank_mask:0x3
    v_add_f32_dpp v46, v83, v83 row_ror:8 row_mask:0xf bank_mask:0xc
    v_add_f32_dpp v84, v45, v45 row_shl:4 row_mask:0xf bank_mask:0x5
    s_nop 0
    v_add_f32_dpp v84, v46, v46 row_shr:4 row_mask:0xf bank_mask:0xa
    s_nop 1
    v_add_f32_dpp v84, v84, v84 quad_perm:[1,0,3,2] row_mask:0xf bank_mask:0xf
    v_cvt_pk_bf16_f32 v84, v84, v84
    ds_write_b16 v71, v84 offset:13056
    s_waitcnt lgkmcnt(0)
    s_waitcnt vmcnt(2)
    buffer_load_dwordx4 v[192:195], v68, s[24:27], 0 offen nt
    v_xor_b32 v68, 0x65700, v2
    s_barrier
    v_lshlrev_b32 v45, 4, v43
    ds_read_b128 v[8:11], v45 offset:13056
    s_waitcnt lgkmcnt(0)
    v_dot2_f32_bf16 v32, v112, v8, 0
    v_dot2_f32_bf16 v33, v116, v8, 0
    v_dot2_f32_bf16 v32, v113, v9, v32
    v_dot2_f32_bf16 v33, v117, v9, v33
    v_dot2_f32_bf16 v32, v114, v10, v32
    v_dot2_f32_bf16 v33, v118, v10, v33
    v_dot2_f32_bf16 v32, v115, v11, v32
    v_dot2_f32_bf16 v33, v119, v11, v33
    v_dot2_f32_bf16 v34, v120, v8, 0
    v_dot2_f32_bf16 v35, v124, v8, 0
    v_dot2_f32_bf16 v34, v121, v9, v34
    v_dot2_f32_bf16 v35, v125, v9, v35
    v_dot2_f32_bf16 v34, v122, v10, v34
    v_dot2_f32_bf16 v35, v126, v10, v35
    v_dot2_f32_bf16 v34, v123, v11, v34
    v_dot2_f32_bf16 v35, v127, v11, v35
    v_dot2_f32_bf16 v36, v128, v8, 0
    v_add_f32_dpp v40, v32, v32 row_ror:8 row_mask:0xf bank_mask:0x3
    v_dot2_f32_bf16 v37, v132, v8, 0
    v_dot2_f32_bf16 v36, v129, v9, v36
    v_add_f32_dpp v40, v33, v33 row_ror:8 row_mask:0xf bank_mask:0xc
    v_dot2_f32_bf16 v37, v133, v9, v37
    v_dot2_f32_bf16 v36, v130, v10, v36
    v_add_f32_dpp v41, v34, v34 row_ror:8 row_mask:0xf bank_mask:0x3
    v_dot2_f32_bf16 v37, v134, v10, v37
    v_dot2_f32_bf16 v36, v131, v11, v36
    v_add_f32_dpp v41, v35, v35 row_ror:8 row_mask:0xf bank_mask:0xc
    v_dot2_f32_bf16 v37, v135, v11, v37
    v_dot2_f32_bf16 v38, v136, v8, 0
    v_add_f32_dpp v16, v40, v40 row_shl:4 row_mask:0xf bank_mask:0x5
    v_dot2_f32_bf16 v39, v140, v8, 0
    v_dot2_f32_bf16 v38, v137, v9, v38
    v_add_f32_dpp v16, v41, v41 row_shr:4 row_mask:0xf bank_mask:0xa
    v_dot2_f32_bf16 v39, v141, v9, v39
    v_dot2_f32_bf16 v38, v138, v10, v38
    v_add_f32_dpp v16, v16, v16 quad_perm:[1,0,3,2] row_mask:0xf bank_mask:0xf
    v_dot2_f32_bf16 v39, v142, v10, v39
    v_dot2_f32_bf16 v38, v139, v11, v38
    v_add_f32_dpp v16, v16, v16 quad_perm:[2,3,0,1] row_mask:0xf bank_mask:0xf
    v_dot2_f32_bf16 v39, v143, v11, v39
    v_dot2_f32_bf16 v32, v144, v8, 0
    s_waitcnt vmcnt(2)
    buffer_load_dwordx4 v[196:199], v68, s[24:27], 0 offen nt
    v_xor_b32 v68, 0x6cf00, v2
    s_barrier
    v_add_f32_dpp v40, v36, v36 row_ror:8 row_mask:0xf bank_mask:0x3
    v_dot2_f32_bf16 v33, v148, v8, 0
    v_dot2_f32_bf16 v32, v145, v9, v32
    v_add_f32_dpp v40, v37, v37 row_ror:8 row_mask:0xf bank_mask:0xc
    v_dot2_f32_bf16 v33, v149, v9, v33
    v_dot2_f32_bf16 v32, v146, v10, v32
    v_add_f32_dpp v41, v38, v38 row_ror:8 row_mask:0xf bank_mask:0x3
    v_dot2_f32_bf16 v33, v150, v10, v33
    v_dot2_f32_bf16 v32, v147, v11, v32
    v_add_f32_dpp v41, v39, v39 row_ror:8 row_mask:0xf bank_mask:0xc
    v_dot2_f32_bf16 v33, v151, v11, v33
    v_dot2_f32_bf16 v34, v152, v8, 0
    v_add_f32_dpp v17, v40, v40 row_shl:4 row_mask:0xf bank_mask:0x5
    v_dot2_f32_bf16 v35, v156, v8, 0
    v_dot2_f32_bf16 v34, v153, v9, v34
    v_add_f32_dpp v17, v41, v41 row_shr:4 row_mask:0xf bank_mask:0xa
    v_dot2_f32_bf16 v35, v157, v9, v35
    v_dot2_f32_bf16 v34, v154, v10, v34
    v_add_f32_dpp v17, v17, v17 quad_perm:[1,0,3,2] row_mask:0xf bank_mask:0xf
    v_dot2_f32_bf16 v35, v158, v10, v35
    v_dot2_f32_bf16 v34, v155, v11, v34
    v_add_f32_dpp v17, v17, v17 quad_perm:[2,3,0,1] row_mask:0xf bank_mask:0xf
    v_dot2_f32_bf16 v35, v159, v11, v35
    v_dot2_f32_bf16 v36, v160, v8, 0
    v_add_f32_dpp v40, v32, v32 row_ror:8 row_mask:0xf bank_mask:0x3
    v_dot2_f32_bf16 v37, v164, v8, 0
    v_dot2_f32_bf16 v36, v161, v9, v36
    v_add_f32_dpp v40, v33, v33 row_ror:8 row_mask:0xf bank_mask:0xc
    v_dot2_f32_bf16 v37, v165, v9, v37
    v_dot2_f32_bf16 v36, v162, v10, v36
    v_add_f32_dpp v41, v34, v34 row_ror:8 row_mask:0xf bank_mask:0x3
    v_dot2_f32_bf16 v37, v166, v10, v37
    v_dot2_f32_bf16 v36, v163, v11, v36
    v_add_f32_dpp v41, v35, v35 row_ror:8 row_mask:0xf bank_mask:0xc
    v_dot2_f32_bf16 v37, v167, v11, v37
    v_dot2_f32_bf16 v38, v168, v8, 0
    v_add_f32_dpp v18, v40, v40 row_shl:4 row_mask:0xf bank_mask:0x5
    v_dot2_f32_bf16 v39, v172, v8, 0
    v_dot2_f32_bf16 v38, v169, v9, v38
    v_add_f32_dpp v18, v41, v41 row_shr:4 row_mask:0xf bank_mask:0xa
    v_dot2_f32_bf16 v39, v173, v9, v39
    v_dot2_f32_bf16 v38, v170, v10, v38
    v_add_f32_dpp v18, v18, v18 quad_perm:[1,0,3,2] row_mask:0xf bank_mask:0xf
    v_dot2_f32_bf16 v39, v174, v10, v39
    s_waitcnt vmcnt(2)
    buffer_load_dwordx4 v[200:203], v68, s[24:27], 0 offen nt
    v_xor_b32 v68, 0x3fb00, v2
    s_barrier
    v_dot2_f32_bf16 v38, v171, v11, v38
    v_add_f32_dpp v18, v18, v18 quad_perm:[2,3,0,1] row_mask:0xf bank_mask:0xf
    v_dot2_f32_bf16 v39, v175, v11, v39
    v_dot2_f32_bf16 v32, v176, v8, 0
    v_add_f32_dpp v40, v36, v36 row_ror:8 row_mask:0xf bank_mask:0x3
    v_dot2_f32_bf16 v32, v177, v9, v32
    v_dot2_f32_bf16 v32, v178, v10, v32
    v_add_f32_dpp v40, v37, v37 row_ror:8 row_mask:0xf bank_mask:0xc
    v_dot2_f32_bf16 v32, v179, v11, v32
    v_dot2_f32_bf16 v33, v180, v8, 0
    v_add_f32_dpp v41, v38, v38 row_ror:8 row_mask:0xf bank_mask:0x3
    v_dot2_f32_bf16 v33, v181, v9, v33
    v_dot2_f32_bf16 v33, v182, v10, v33
    v_add_f32_dpp v41, v39, v39 row_ror:8 row_mask:0xf bank_mask:0xc
    v_dot2_f32_bf16 v33, v183, v11, v33
    v_dot2_f32_bf16 v34, v184, v8, 0
    v_add_f32_dpp v19, v40, v40 row_shl:4 row_mask:0xf bank_mask:0x5
    v_dot2_f32_bf16 v34, v185, v9, v34
    v_dot2_f32_bf16 v34, v186, v10, v34
    v_add_f32_dpp v19, v41, v41 row_shr:4 row_mask:0xf bank_mask:0xa
    v_dot2_f32_bf16 v34, v187, v11, v34
    v_dot2_f32_bf16 v35, v188, v8, 0
    v_add_f32_dpp v19, v19, v19 quad_perm:[1,0,3,2] row_mask:0xf bank_mask:0xf
    v_dot2_f32_bf16 v35, v189, v9, v35
    v_dot2_f32_bf16 v35, v190, v10, v35
    v_add_f32_dpp v19, v19, v19 quad_perm:[2,3,0,1] row_mask:0xf bank_mask:0xf
    v_dot2_f32_bf16 v35, v191, v11, v35
    s_waitcnt vmcnt(2)
    buffer_load_dwordx4 v[204:207], v68, s[24:27], 0 offen nt
    v_xor_b32 v68, 0xc0b00, v2
    s_barrier
    v_dot2_f32_bf16 v36, v192, v8, 0
    v_add_f32_dpp v40, v32, v32 row_ror:8 row_mask:0xf bank_mask:0x3
    v_dot2_f32_bf16 v36, v193, v9, v36
    v_dot2_f32_bf16 v36, v194, v10, v36
    v_add_f32_dpp v40, v33, v33 row_ror:8 row_mask:0xf bank_mask:0xc
    v_dot2_f32_bf16 v36, v195, v11, v36
    s_waitcnt vmcnt(2)
    buffer_load_dwordx4 v[208:211], v68, s[24:27], 0 offen nt
    v_xor_b32 v68, 0x93f00, v2
    s_barrier
    v_dot2_f32_bf16 v37, v196, v8, 0
    v_add_f32_dpp v41, v34, v34 row_ror:8 row_mask:0xf bank_mask:0x3
    v_dot2_f32_bf16 v37, v197, v9, v37
    v_dot2_f32_bf16 v37, v198, v10, v37
    v_add_f32_dpp v41, v35, v35 row_ror:8 row_mask:0xf bank_mask:0xc
    v_dot2_f32_bf16 v37, v199, v11, v37
    s_waitcnt vmcnt(2)
    buffer_load_dwordx4 v[212:215], v68, s[24:27], 0 offen nt
    v_xor_b32 v68, 0x9a700, v2
    s_barrier
    v_dot2_f32_bf16 v38, v200, v8, 0
    v_add_f32_dpp v20, v40, v40 row_shl:4 row_mask:0xf bank_mask:0x5
    v_dot2_f32_bf16 v38, v201, v9, v38
    v_dot2_f32_bf16 v38, v202, v10, v38
    v_add_f32_dpp v20, v41, v41 row_shr:4 row_mask:0xf bank_mask:0xa
    v_dot2_f32_bf16 v38, v203, v11, v38
    s_waitcnt vmcnt(2)
    buffer_load_dwordx4 v[216:219], v68, s[24:27], 0 offen nt
    v_xor_b32 v68, 0xc9300, v2
    s_barrier
    v_dot2_f32_bf16 v39, v204, v8, 0
    v_add_f32_dpp v20, v20, v20 quad_perm:[1,0,3,2] row_mask:0xf bank_mask:0xf
    v_dot2_f32_bf16 v39, v205, v9, v39
    v_dot2_f32_bf16 v39, v206, v10, v39
    v_add_f32_dpp v20, v20, v20 quad_perm:[2,3,0,1] row_mask:0xf bank_mask:0xf
    v_dot2_f32_bf16 v39, v207, v11, v39
    s_waitcnt vmcnt(2)
    buffer_load_dwordx4 v[220:223], v68, s[24:27], 0 offen nt
    v_xor_b32 v68, 0x5ee00, v2
    s_barrier
    buffer_load_dwordx4 v[224:227], v68, s[24:27], 0 offen nt
    v_xor_b32 v68, 0xda00, v2
    s_barrier
    buffer_load_dwordx4 v[228:231], v68, s[24:27], 0 offen nt
    v_xor_b32 v68, 0x4200, v2
    s_barrier
    buffer_load_dwordx4 v[232:235], v68, s[24:27], 0 offen nt
    v_xor_b32 v68, 0x57600, v2
    s_barrier
    v_dot2_f32_bf16 v32, v208, v8, 0
    v_add_f32_dpp v40, v36, v36 row_ror:8 row_mask:0xf bank_mask:0x3
    v_dot2_f32_bf16 v32, v209, v9, v32
    v_dot2_f32_bf16 v32, v210, v10, v32
    v_add_f32_dpp v40, v37, v37 row_ror:8 row_mask:0xf bank_mask:0xc
    v_dot2_f32_bf16 v32, v211, v11, v32
    s_waitcnt vmcnt(5)
    buffer_load_dwordx4 v[236:239], v68, s[24:27], 0 offen nt
    s_barrier
    v_dot2_f32_bf16 v33, v212, v8, 0
    v_add_f32_dpp v41, v38, v38 row_ror:8 row_mask:0xf bank_mask:0x3
    v_dot2_f32_bf16 v33, v213, v9, v33
    v_dot2_f32_bf16 v33, v214, v10, v33
    v_add_f32_dpp v41, v39, v39 row_ror:8 row_mask:0xf bank_mask:0xc
    v_dot2_f32_bf16 v33, v215, v11, v33
    s_waitcnt vmcnt(5)
    buffer_load_dwordx4 v[240:243], v2, s[28:31], 0 offen nt
    v_xor_b32 v68, 0x53400, v2
    s_barrier
    v_dot2_f32_bf16 v34, v216, v8, 0
    v_add_f32_dpp v21, v40, v40 row_shl:4 row_mask:0xf bank_mask:0x5
    v_dot2_f32_bf16 v34, v217, v9, v34
    v_dot2_f32_bf16 v34, v218, v10, v34
    v_add_f32_dpp v21, v41, v41 row_shr:4 row_mask:0xf bank_mask:0xa
    v_dot2_f32_bf16 v34, v219, v11, v34
    s_waitcnt vmcnt(5)
    buffer_load_dwordx4 v[244:247], v68, s[28:31], 0 offen nt
    v_xor_b32 v68, 0x5ac00, v2
    s_barrier
    v_dot2_f32_bf16 v35, v220, v8, 0
    v_add_f32_dpp v21, v21, v21 quad_perm:[1,0,3,2] row_mask:0xf bank_mask:0xf
    v_dot2_f32_bf16 v35, v221, v9, v35
    v_dot2_f32_bf16 v35, v222, v10, v35
    v_add_f32_dpp v21, v21, v21 quad_perm:[2,3,0,1] row_mask:0xf bank_mask:0xf
    v_dot2_f32_bf16 v35, v223, v11, v35
    s_waitcnt vmcnt(5)
    buffer_load_dwordx4 v[248:251], v68, s[28:31], 0 offen nt
    v_xor_b32 v68, 0x9800, v2
    s_barrier
    v_dot2_f32_bf16 v36, v224, v8, 0
    v_add_f32_dpp v40, v32, v32 row_ror:8 row_mask:0xf bank_mask:0x3
    v_dot2_f32_bf16 v36, v225, v9, v36
    v_dot2_f32_bf16 v36, v226, v10, v36
    v_add_f32_dpp v40, v33, v33 row_ror:8 row_mask:0xf bank_mask:0xc
    v_dot2_f32_bf16 v36, v227, v11, v36
    s_waitcnt vmcnt(5)
    buffer_load_dwordx4 v[252:255], v68, s[28:31], 0 offen nt
    v_xor_b32 v68, 0x9e500, v2
    s_barrier
    v_dot2_f32_bf16 v37, v228, v8, 0
    v_add_f32_dpp v41, v34, v34 row_ror:8 row_mask:0xf bank_mask:0x3
    v_dot2_f32_bf16 v37, v229, v9, v37
    v_dot2_f32_bf16 v37, v230, v10, v37
    v_add_f32_dpp v41, v35, v35 row_ror:8 row_mask:0xf bank_mask:0xc
    v_dot2_f32_bf16 v37, v231, v11, v37
    s_waitcnt vmcnt(5)
    buffer_load_dwordx4 v[112:115], v68, s[28:31], 0 offen nt
    v_xor_b32 v68, 0xcd100, v2
    s_barrier
    v_dot2_f32_bf16 v38, v232, v8, 0
    v_add_f32_dpp v22, v40, v40 row_shl:4 row_mask:0xf bank_mask:0x5
    v_dot2_f32_bf16 v38, v233, v9, v38
    v_dot2_f32_bf16 v38, v234, v10, v38
    v_add_f32_dpp v22, v41, v41 row_shr:4 row_mask:0xf bank_mask:0xa
    v_dot2_f32_bf16 v38, v235, v11, v38
    s_waitcnt vmcnt(5)
    buffer_load_dwordx4 v[116:119], v68, s[28:31], 0 offen nt
    v_xor_b32 v68, 0xc4900, v2
    s_barrier
    v_dot2_f32_bf16 v39, v236, v8, 0
    v_add_f32_dpp v22, v22, v22 quad_perm:[1,0,3,2] row_mask:0xf bank_mask:0xf
    v_dot2_f32_bf16 v39, v237, v9, v39
    v_dot2_f32_bf16 v39, v238, v10, v39
    v_add_f32_dpp v22, v22, v22 quad_perm:[2,3,0,1] row_mask:0xf bank_mask:0xf
    v_dot2_f32_bf16 v39, v239, v11, v39
    v_add_f32_dpp v40, v36, v36 row_ror:8 row_mask:0xf bank_mask:0x3
    v_add_f32_dpp v40, v37, v37 row_ror:8 row_mask:0xf bank_mask:0xc
    v_add_f32_dpp v41, v38, v38 row_ror:8 row_mask:0xf bank_mask:0x3
    v_add_f32_dpp v41, v39, v39 row_ror:8 row_mask:0xf bank_mask:0xc
    v_add_f32_dpp v23, v40, v40 row_shl:4 row_mask:0xf bank_mask:0x5
    s_nop 0
    v_add_f32_dpp v23, v41, v41 row_shr:4 row_mask:0xf bank_mask:0xa
    s_nop 1
    v_add_f32_dpp v23, v23, v23 quad_perm:[1,0,3,2] row_mask:0xf bank_mask:0xf
    s_nop 1
    v_add_f32_dpp v23, v23, v23 quad_perm:[2,3,0,1] row_mask:0xf bank_mask:0xf
    v_cvt_pk_bf16_f32 v17, v16, v17
    v_cvt_pk_bf16_f32 v19, v18, v19
    v_cvt_pk_bf16_f32 v21, v20, v21
    v_cvt_pk_bf16_f32 v23, v22, v23
    v_lshlrev_b32 v16, 16, v17
    v_and_b32 v17, 0xffff0000, v17
    v_lshlrev_b32 v18, 16, v19
    v_and_b32 v19, 0xffff0000, v19
    v_lshlrev_b32 v20, 16, v21
    v_and_b32 v21, 0xffff0000, v21
    v_lshlrev_b32 v22, 16, v23
    v_and_b32 v23, 0xffff0000, v23
    v_mul_f32 v16, 0x3db504f3, v16
    v_mul_f32 v17, 0x3db504f3, v17
    v_mul_f32 v18, 0x3db504f3, v18
    v_mul_f32 v19, 0x3db504f3, v19
    v_mul_f32 v20, 0x3db504f3, v20
    v_mul_f32 v21, 0x3db504f3, v21
    v_mul_f32 v22, 0x3db504f3, v22
    v_mul_f32 v23, 0x3db504f3, v23
    v_cvt_pk_bf16_f32 v17, v16, v17
    v_cvt_pk_bf16_f32 v19, v18, v19
    v_cvt_pk_bf16_f32 v21, v20, v21
    v_cvt_pk_bf16_f32 v23, v22, v23
    v_lshlrev_b32 v16, 16, v17
    v_and_b32 v17, 0xffff0000, v17
    v_lshlrev_b32 v18, 16, v19
    v_and_b32 v19, 0xffff0000, v19
    v_lshlrev_b32 v20, 16, v21
    v_and_b32 v21, 0xffff0000, v21
    s_waitcnt vmcnt(5)
    buffer_load_dwordx4 v[120:123], v68, s[28:31], 0 offen nt
    v_xor_b32 v68, 0x97d00, v2
    s_barrier
    v_lshlrev_b32 v22, 16, v23
    v_and_b32 v23, 0xffff0000, v23
    v_max3_f32 v59, v16, v17, v18
    v_max3_f32 v59, v59, v19, v20
    v_max3_f32 v59, v59, v21, v22
    v_max_f32 v59, v59, v23
    s_nop 1
    v_max_f32_dpp v59, v59, v59 row_ror:4 row_mask:0xf bank_mask:0xf
    s_nop 1
    v_max_f32_dpp v59, v59, v59 row_ror:8 row_mask:0xf bank_mask:0xf
    v_mov_b32 v45, v59
    s_nop 1
    v_permlane16_swap_b32 v59, v45
    v_max_f32 v59, v59, v45
    v_mov_b32 v45, v59
    s_nop 1
    v_permlane32_swap_b32 v59, v45
    v_max_f32 v59, v59, v45
    v_sub_f32 v16, v16, v59
    v_sub_f32 v17, v17, v59
    v_sub_f32 v18, v18, v59
    v_sub_f32 v19, v19, v59
    v_sub_f32 v20, v20, v59
    v_sub_f32 v21, v21, v59
    v_sub_f32 v22, v22, v59
    v_sub_f32 v23, v23, v59
    v_mul_f32 v16, s57, v16
    v_mul_f32 v17, s57, v17
    v_mul_f32 v18, s57, v18
    v_mul_f32 v19, s57, v19
    v_mul_f32 v20, s57, v20
    v_mul_f32 v21, s57, v21
    v_mul_f32 v22, s57, v22
    v_mul_f32 v23, s57, v23
    v_exp_f32 v16, v16
    v_exp_f32 v17, v17
    v_exp_f32 v18, v18
    v_exp_f32 v19, v19
    v_exp_f32 v20, v20
    v_exp_f32 v21, v21
    v_exp_f32 v22, v22
    v_exp_f32 v23, v23
    v_add_f32 v34, v16, v17
    v_add_f32 v34, v34, v18
    v_add_f32 v34, v34, v19
    v_add_f32 v34, v34, v20
    v_add_f32 v34, v34, v21
    v_add_f32 v34, v34, v22
    s_waitcnt vmcnt(5)
    buffer_load_dwordx4 v[124:127], v68, s[28:31], 0 offen nt
    v_xor_b32 v68, 0x68d00, v2
    s_barrier
    v_add_f32 v34, v34, v23
    v_cvt_pk_bf16_f32 v16, v16, v16
    v_cvt_pk_bf16_f32 v17, v17, v17
    v_cvt_pk_bf16_f32 v18, v18, v18
    v_cvt_pk_bf16_f32 v19, v19, v19
    v_cvt_pk_bf16_f32 v20, v20, v20
    v_cvt_pk_bf16_f32 v21, v21, v21
    v_add_f32_dpp v34, v34, v34 row_ror:4 row_mask:0xf bank_mask:0xf
    v_mov_b32 v32, v59
    v_mov_b32 v33, s53
    v_add_f32_dpp v34, v34, v34 row_ror:8 row_mask:0xf bank_mask:0xf
    v_mov_b32 v35, s98
    v_mov_b32 v45, v34
    s_nop 1
    v_permlane16_swap_b32 v34, v45
    v_add_f32 v34, v34, v45
    v_mov_b32 v45, v34
    s_nop 1
    v_permlane32_swap_b32 v34, v45
    v_add_f32 v34, v34, v45
    s_mov_b64 exec, 1
    v_lshrrev_b32 v45, 2, v0
    ds_write_b128 v45, v[32:35] offset:13312
    s_mov_b64 exec, -1
    v_and_b32_dpp v24, v16, v4 row_newbcast:0 row_mask:0xf bank_mask:0xf
    v_and_b32_dpp v25, v16, v5 row_newbcast:0 row_mask:0xf bank_mask:0xf
    v_and_b32_dpp v26, v16, v6 row_newbcast:0 row_mask:0xf bank_mask:0xf
    v_and_b32_dpp v27, v16, v7 row_newbcast:0 row_mask:0xf bank_mask:0xf
    s_waitcnt lgkmcnt(0)
    s_waitcnt vmcnt(5)
    s_waitcnt vmcnt(4)
    s_waitcnt vmcnt(3)
    s_waitcnt vmcnt(2)
    buffer_load_dwordx4 v[128:131], v68, s[28:31], 0 offen nt
    v_xor_b32 v68, 0x3b900, v2
    s_barrier
    s_cmp_lg_u32 s20, 0
    s_cbranch_scc1 L_ml_sent
    s_mov_b64 exec, 0xff
    ds_read_b128 v[32:35], v66 offset:13312
    v_add_u32 v45, v55, v66
    s_waitcnt lgkmcnt(0)
    buffer_store_dwordx4 v[32:35], v45, s[44:47], 0 offen sc1
    s_mov_b64 exec, -1
L_ml_sent:
    v_mfma_f32_16x16x32_bf16 v[12:15], v[24:27], v[240:243], 0
    v_and_b32_dpp v28, v16, v4 row_newbcast:8 row_mask:0xf bank_mask:0xf
    v_and_b32_dpp v29, v16, v5 row_newbcast:8 row_mask:0xf bank_mask:0xf
    v_and_b32_dpp v30, v16, v6 row_newbcast:8 row_mask:0xf bank_mask:0xf
    v_and_b32_dpp v31, v16, v7 row_newbcast:8 row_mask:0xf bank_mask:0xf
    s_nop 1
    v_mfma_f32_16x16x32_bf16 v[12:15], v[28:31], v[244:247], v[12:15]
    v_and_b32_dpp v24, v16, v4 row_newbcast:4 row_mask:0xf bank_mask:0xf
    v_and_b32_dpp v25, v16, v5 row_newbcast:4 row_mask:0xf bank_mask:0xf
    v_and_b32_dpp v26, v16, v6 row_newbcast:4 row_mask:0xf bank_mask:0xf
    v_and_b32_dpp v27, v16, v7 row_newbcast:4 row_mask:0xf bank_mask:0xf
    s_nop 1
    v_mfma_f32_16x16x32_bf16 v[12:15], v[24:27], v[248:251], v[12:15]
    v_and_b32_dpp v28, v16, v4 row_newbcast:12 row_mask:0xf bank_mask:0xf
    v_and_b32_dpp v29, v16, v5 row_newbcast:12 row_mask:0xf bank_mask:0xf
    v_and_b32_dpp v30, v16, v6 row_newbcast:12 row_mask:0xf bank_mask:0xf
    v_and_b32_dpp v31, v16, v7 row_newbcast:12 row_mask:0xf bank_mask:0xf
    s_nop 1
    v_mfma_f32_16x16x32_bf16 v[12:15], v[28:31], v[252:255], v[12:15]
    v_and_b32_dpp v24, v17, v4 row_newbcast:0 row_mask:0xf bank_mask:0xf
    v_and_b32_dpp v25, v17, v5 row_newbcast:0 row_mask:0xf bank_mask:0xf
    v_and_b32_dpp v26, v17, v6 row_newbcast:0 row_mask:0xf bank_mask:0xf
    v_and_b32_dpp v27, v17, v7 row_newbcast:0 row_mask:0xf bank_mask:0xf
    s_nop 1
    v_mfma_f32_16x16x32_bf16 v[12:15], v[24:27], v[112:115], v[12:15]
    v_and_b32_dpp v28, v17, v4 row_newbcast:8 row_mask:0xf bank_mask:0xf
    v_and_b32_dpp v29, v17, v5 row_newbcast:8 row_mask:0xf bank_mask:0xf
    v_and_b32_dpp v30, v17, v6 row_newbcast:8 row_mask:0xf bank_mask:0xf
    v_and_b32_dpp v31, v17, v7 row_newbcast:8 row_mask:0xf bank_mask:0xf
    s_nop 1
    v_mfma_f32_16x16x32_bf16 v[12:15], v[28:31], v[116:119], v[12:15]
    v_and_b32_dpp v24, v17, v4 row_newbcast:4 row_mask:0xf bank_mask:0xf
    v_and_b32_dpp v25, v17, v5 row_newbcast:4 row_mask:0xf bank_mask:0xf
    v_and_b32_dpp v26, v17, v6 row_newbcast:4 row_mask:0xf bank_mask:0xf
    v_and_b32_dpp v27, v17, v7 row_newbcast:4 row_mask:0xf bank_mask:0xf
    s_waitcnt vmcnt(2)
    buffer_load_dwordx4 v[132:135], v68, s[28:31], 0 offen nt
    v_xor_b32 v68, 0x32100, v2
    s_barrier
    v_mfma_f32_16x16x32_bf16 v[12:15], v[24:27], v[120:123], v[12:15]
    v_and_b32_dpp v28, v17, v4 row_newbcast:12 row_mask:0xf bank_mask:0xf
    v_and_b32_dpp v29, v17, v5 row_newbcast:12 row_mask:0xf bank_mask:0xf
    v_and_b32_dpp v30, v17, v6 row_newbcast:12 row_mask:0xf bank_mask:0xf
    v_and_b32_dpp v31, v17, v7 row_newbcast:12 row_mask:0xf bank_mask:0xf
    s_waitcnt vmcnt(2)
    buffer_load_dwordx4 v[136:139], v68, s[28:31], 0 offen nt
    v_xor_b32 v68, 0x61500, v2
    s_barrier
    v_mfma_f32_16x16x32_bf16 v[12:15], v[28:31], v[124:127], v[12:15]
    v_and_b32_dpp v24, v18, v4 row_newbcast:0 row_mask:0xf bank_mask:0xf
    v_and_b32_dpp v25, v18, v5 row_newbcast:0 row_mask:0xf bank_mask:0xf
    v_and_b32_dpp v26, v18, v6 row_newbcast:0 row_mask:0xf bank_mask:0xf
    v_and_b32_dpp v27, v18, v7 row_newbcast:0 row_mask:0xf bank_mask:0xf
    s_waitcnt vmcnt(2)
    buffer_load_dwordx4 v[140:143], v68, s[28:31], 0 offen nt
    v_xor_b32 v68, 0xf6800, v2
    s_barrier
    v_mfma_f32_16x16x32_bf16 v[12:15], v[24:27], v[128:131], v[12:15]
    v_and_b32_dpp v28, v18, v4 row_newbcast:8 row_mask:0xf bank_mask:0xf
    v_and_b32_dpp v29, v18, v5 row_newbcast:8 row_mask:0xf bank_mask:0xf
    v_and_b32_dpp v30, v18, v6 row_newbcast:8 row_mask:0xf bank_mask:0xf
    v_and_b32_dpp v31, v18, v7 row_newbcast:8 row_mask:0xf bank_mask:0xf
    s_waitcnt vmcnt(2)
    buffer_load_dwordx4 v[144:147], v68, s[28:31], 0 offen nt
    v_xor_b32 v68, 0xa5c00, v2
    s_barrier
    v_mfma_f32_16x16x32_bf16 v[12:15], v[28:31], v[132:135], v[12:15]
    v_and_b32_dpp v24, v18, v4 row_newbcast:4 row_mask:0xf bank_mask:0xf
    v_and_b32_dpp v25, v18, v5 row_newbcast:4 row_mask:0xf bank_mask:0xf
    v_and_b32_dpp v26, v18, v6 row_newbcast:4 row_mask:0xf bank_mask:0xf
    v_and_b32_dpp v27, v18, v7 row_newbcast:4 row_mask:0xf bank_mask:0xf
    s_waitcnt vmcnt(2)
    buffer_load_dwordx4 v[148:151], v68, s[28:31], 0 offen nt
    v_xor_b32 v68, 0xac400, v2
    s_barrier
    v_mfma_f32_16x16x32_bf16 v[12:15], v[24:27], v[136:139], v[12:15]
    v_and_b32_dpp v28, v18, v4 row_newbcast:12 row_mask:0xf bank_mask:0xf
    v_and_b32_dpp v29, v18, v5 row_newbcast:12 row_mask:0xf bank_mask:0xf
    v_and_b32_dpp v30, v18, v6 row_newbcast:12 row_mask:0xf bank_mask:0xf
    v_and_b32_dpp v31, v18, v7 row_newbcast:12 row_mask:0xf bank_mask:0xf
    s_waitcnt vmcnt(2)
    buffer_load_dwordx4 v[152:155], v68, s[28:31], 0 offen nt
    v_xor_b32 v68, 0xff000, v2
    s_barrier
    v_mfma_f32_16x16x32_bf16 v[12:15], v[28:31], v[140:143], v[12:15]
    v_and_b32_dpp v24, v19, v4 row_newbcast:0 row_mask:0xf bank_mask:0xf
    v_and_b32_dpp v25, v19, v5 row_newbcast:0 row_mask:0xf bank_mask:0xf
    v_and_b32_dpp v26, v19, v6 row_newbcast:0 row_mask:0xf bank_mask:0xf
    v_and_b32_dpp v27, v19, v7 row_newbcast:0 row_mask:0xf bank_mask:0xf
    s_waitcnt vmcnt(2)
    buffer_load_dwordx4 v[156:159], v68, s[28:31], 0 offen nt
    v_xor_b32 v68, 0xa8600, v2
    s_barrier
    v_mfma_f32_16x16x32_bf16 v[12:15], v[24:27], v[144:147], v[12:15]
    v_and_b32_dpp v28, v19, v4 row_newbcast:8 row_mask:0xf bank_mask:0xf
    v_and_b32_dpp v29, v19, v5 row_newbcast:8 row_mask:0xf bank_mask:0xf
    v_and_b32_dpp v30, v19, v6 row_newbcast:8 row_mask:0xf bank_mask:0xf
    v_and_b32_dpp v31, v19, v7 row_newbcast:8 row_mask:0xf bank_mask:0xf
    s_waitcnt vmcnt(2)
    buffer_load_dwordx4 v[36:39], v56, s[44:47], 0 offen sc1
    buffer_load_dwordx4 v[160:163], v68, s[28:31], 0 offen nt
    v_xor_b32 v68, 0xfb200, v2
    s_barrier
    v_mfma_f32_16x16x32_bf16 v[12:15], v[28:31], v[148:151], v[12:15]
    v_and_b32_dpp v24, v19, v4 row_newbcast:4 row_mask:0xf bank_mask:0xf
    v_and_b32_dpp v25, v19, v5 row_newbcast:4 row_mask:0xf bank_mask:0xf
    v_and_b32_dpp v26, v19, v6 row_newbcast:4 row_mask:0xf bank_mask:0xf
    v_and_b32_dpp v27, v19, v7 row_newbcast:4 row_mask:0xf bank_mask:0xf
    s_waitcnt vmcnt(3)
    buffer_load_dwordx4 v[164:167], v68, s[28:31], 0 offen nt
    v_xor_b32 v68, 0xf2a00, v2
    s_barrier
    v_mfma_f32_16x16x32_bf16 v[12:15], v[24:27], v[152:155], v[12:15]
    v_and_b32_dpp v28, v19, v4 row_newbcast:12 row_mask:0xf bank_mask:0xf
    v_and_b32_dpp v29, v19, v5 row_newbcast:12 row_mask:0xf bank_mask:0xf
    v_and_b32_dpp v30, v19, v6 row_newbcast:12 row_mask:0xf bank_mask:0xf
    v_and_b32_dpp v31, v19, v7 row_newbcast:12 row_mask:0xf bank_mask:0xf
    s_waitcnt vmcnt(3)
    buffer_load_dwordx4 v[168:171], v68, s[28:31], 0 offen nt
    v_xor_b32 v68, 0xa1e00, v2
    s_barrier
    v_mfma_f32_16x16x32_bf16 v[12:15], v[28:31], v[156:159], v[12:15]
    v_and_b32_dpp v24, v20, v4 row_newbcast:0 row_mask:0xf bank_mask:0xf
    v_and_b32_dpp v25, v20, v5 row_newbcast:0 row_mask:0xf bank_mask:0xf
    v_and_b32_dpp v26, v20, v6 row_newbcast:0 row_mask:0xf bank_mask:0xf
    v_and_b32_dpp v27, v20, v7 row_newbcast:0 row_mask:0xf bank_mask:0xf
    s_waitcnt vmcnt(2)
    buffer_load_dwordx4 v[172:175], v68, s[28:31], 0 offen nt
    v_xor_b32 v68, 0x36300, v2
    s_barrier
L_ml_check:
    v_xor_b32 v45, s53, v37
    v_xor_b32 v46, s98, v39
    v_and_or_b32 v45, v46, -16, v45
    v_cmp_ne_u32 vcc, 0, v45
    s_cbranch_vccnz L_ml_retry
L_ml_ok:
    v_cmp_ne_u32 s[100:101], 0, v46
    v_max_f32_dpp v46, v36, v36 quad_perm:[1,0,3,2] row_mask:0xf bank_mask:0xf
    s_nop 1
    v_max_f32_dpp v46, v46, v46 quad_perm:[2,3,0,1] row_mask:0xf bank_mask:0xf
    s_nop 1
    v_max_f32_dpp v46, v46, v46 row_ror:4 row_mask:0xf bank_mask:0xf
    s_nop 1
    v_max_f32_dpp v46, v46, v46 row_ror:8 row_mask:0xf bank_mask:0xf
    v_mov_b32 v45, v46
    s_nop 1
    v_permlane16_swap_b32 v46, v45
    v_max_f32 v46, v46, v45
    v_sub_f32 v36, v36, v46
    v_sub_f32 v60, v59, v46
    v_mul_f32 v36, s57, v36
    v_mul_f32 v60, s57, v60
    v_exp_f32 v36, v36
    v_exp_f32 v60, v60
    v_mul_f32 v36, v36, v38
    s_nop 1
    v_add_f32_dpp v36, v36, v36 quad_perm:[1,0,3,2] row_mask:0xf bank_mask:0xf
    s_nop 1
    v_add_f32_dpp v36, v36, v36 quad_perm:[2,3,0,1] row_mask:0xf bank_mask:0xf
    s_nop 1
    v_add_f32_dpp v36, v36, v36 row_ror:4 row_mask:0xf bank_mask:0xf
    s_nop 1
    v_add_f32_dpp v36, v36, v36 row_ror:8 row_mask:0xf bank_mask:0xf
    v_mov_b32 v45, v36
    s_nop 1
    v_permlane16_swap_b32 v36, v45
    v_add_f32 v36, v36, v45
    v_rcp_f32 v36, v36
    s_nop 0
    v_mul_f32 v60, v60, v36
    s_nop 0
    v_readfirstlane_b32 s57, v60
    s_nop 1
    v_mul_f32 v22, s57, v22
    v_mul_f32 v23, s57, v23
    v_cvt_pk_bf16_f32 v22, v22, v22
    v_cvt_pk_bf16_f32 v23, v23, v23
    v_mfma_f32_16x16x32_bf16 v[12:15], v[24:27], v[160:163], v[12:15]
    v_and_b32_dpp v28, v20, v4 row_newbcast:8 row_mask:0xf bank_mask:0xf
    v_and_b32_dpp v29, v20, v5 row_newbcast:8 row_mask:0xf bank_mask:0xf
    v_and_b32_dpp v30, v20, v6 row_newbcast:8 row_mask:0xf bank_mask:0xf
    v_and_b32_dpp v31, v20, v7 row_newbcast:8 row_mask:0xf bank_mask:0xf
    s_waitcnt vmcnt(2)
    buffer_load_dwordx4 v[176:179], v68, s[28:31], 0 offen nt
    v_xor_b32 v68, 0x65700, v2
    s_barrier
    v_mfma_f32_16x16x32_bf16 v[12:15], v[28:31], v[164:167], v[12:15]
    v_and_b32_dpp v24, v20, v4 row_newbcast:4 row_mask:0xf bank_mask:0xf
    v_and_b32_dpp v25, v20, v5 row_newbcast:4 row_mask:0xf bank_mask:0xf
    v_and_b32_dpp v26, v20, v6 row_newbcast:4 row_mask:0xf bank_mask:0xf
    v_and_b32_dpp v27, v20, v7 row_newbcast:4 row_mask:0xf bank_mask:0xf
    s_waitcnt vmcnt(2)
    buffer_load_dwordx4 v[180:183], v68, s[28:31], 0 offen nt
    v_xor_b32 v68, 0x6cf00, v2
    s_barrier
    v_mfma_f32_16x16x32_bf16 v[12:15], v[24:27], v[168:171], v[12:15]
    v_and_b32_dpp v28, v20, v4 row_newbcast:12 row_mask:0xf bank_mask:0xf
    v_and_b32_dpp v29, v20, v5 row_newbcast:12 row_mask:0xf bank_mask:0xf
    v_and_b32_dpp v30, v20, v6 row_newbcast:12 row_mask:0xf bank_mask:0xf
    v_and_b32_dpp v31, v20, v7 row_newbcast:12 row_mask:0xf bank_mask:0xf
    s_waitcnt vmcnt(2)
    buffer_load_dwordx4 v[184:187], v68, s[28:31], 0 offen nt
    v_xor_b32 v68, 0x3fb00, v2
    s_barrier
    v_mfma_f32_16x16x32_bf16 v[12:15], v[28:31], v[172:175], v[12:15]
    v_and_b32_dpp v24, v21, v4 row_newbcast:0 row_mask:0xf bank_mask:0xf
    v_and_b32_dpp v25, v21, v5 row_newbcast:0 row_mask:0xf bank_mask:0xf
    v_and_b32_dpp v26, v21, v6 row_newbcast:0 row_mask:0xf bank_mask:0xf
    v_and_b32_dpp v27, v21, v7 row_newbcast:0 row_mask:0xf bank_mask:0xf
    s_waitcnt vmcnt(2)
    buffer_load_dwordx4 v[188:191], v68, s[28:31], 0 offen nt
    v_xor_b32 v68, 0xc0b00, v2
    s_barrier
    v_mfma_f32_16x16x32_bf16 v[12:15], v[24:27], v[176:179], v[12:15]
    v_and_b32_dpp v28, v21, v4 row_newbcast:8 row_mask:0xf bank_mask:0xf
    v_and_b32_dpp v29, v21, v5 row_newbcast:8 row_mask:0xf bank_mask:0xf
    v_and_b32_dpp v30, v21, v6 row_newbcast:8 row_mask:0xf bank_mask:0xf
    v_and_b32_dpp v31, v21, v7 row_newbcast:8 row_mask:0xf bank_mask:0xf
    s_waitcnt vmcnt(2)
    buffer_load_dwordx4 v[192:195], v68, s[28:31], 0 offen nt
    v_xor_b32 v68, 0x93f00, v2
    s_barrier
    v_mfma_f32_16x16x32_bf16 v[12:15], v[28:31], v[180:183], v[12:15]
    v_and_b32_dpp v24, v21, v4 row_newbcast:4 row_mask:0xf bank_mask:0xf
    v_and_b32_dpp v25, v21, v5 row_newbcast:4 row_mask:0xf bank_mask:0xf
    v_and_b32_dpp v26, v21, v6 row_newbcast:4 row_mask:0xf bank_mask:0xf
    v_and_b32_dpp v27, v21, v7 row_newbcast:4 row_mask:0xf bank_mask:0xf
    s_waitcnt vmcnt(2)
    buffer_load_dwordx4 v[196:199], v68, s[28:31], 0 offen nt
    v_xor_b32 v68, 0x9a700, v2
    s_barrier
    v_mfma_f32_16x16x32_bf16 v[12:15], v[24:27], v[184:187], v[12:15]
    v_and_b32_dpp v28, v21, v4 row_newbcast:12 row_mask:0xf bank_mask:0xf
    v_and_b32_dpp v29, v21, v5 row_newbcast:12 row_mask:0xf bank_mask:0xf
    v_and_b32_dpp v30, v21, v6 row_newbcast:12 row_mask:0xf bank_mask:0xf
    v_and_b32_dpp v31, v21, v7 row_newbcast:12 row_mask:0xf bank_mask:0xf
    s_waitcnt vmcnt(2)
    buffer_load_dwordx4 v[200:203], v68, s[28:31], 0 offen nt
    v_xor_b32 v68, 0xc9300, v2
    s_barrier
    v_mfma_f32_16x16x32_bf16 v[12:15], v[28:31], v[188:191], v[12:15]
    v_and_b32_dpp v24, v22, v4 row_newbcast:0 row_mask:0xf bank_mask:0xf
    v_and_b32_dpp v25, v22, v5 row_newbcast:0 row_mask:0xf bank_mask:0xf
    v_and_b32_dpp v26, v22, v6 row_newbcast:0 row_mask:0xf bank_mask:0xf
    v_and_b32_dpp v27, v22, v7 row_newbcast:0 row_mask:0xf bank_mask:0xf
    s_waitcnt vmcnt(2)
    buffer_load_dwordx4 v[204:207], v68, s[28:31], 0 offen nt
    v_xor_b32 v68, 0x5ee00, v2
    s_barrier
    v_mul_f32 v12, s57, v12
    v_mul_f32 v13, s57, v13
    v_mul_f32 v14, s57, v14
    v_mul_f32 v15, s57, v15
    s_nop 1
    v_mfma_f32_16x16x32_bf16 v[12:15], v[24:27], v[192:195], v[12:15]
    v_and_b32_dpp v28, v22, v4 row_newbcast:8 row_mask:0xf bank_mask:0xf
    v_and_b32_dpp v29, v22, v5 row_newbcast:8 row_mask:0xf bank_mask:0xf
    v_and_b32_dpp v30, v22, v6 row_newbcast:8 row_mask:0xf bank_mask:0xf
    v_and_b32_dpp v31, v22, v7 row_newbcast:8 row_mask:0xf bank_mask:0xf
    s_waitcnt vmcnt(2)
    buffer_load_dwordx4 v[208:211], v68, s[28:31], 0 offen nt
    v_xor_b32 v68, 0xda00, v2
    s_barrier
    v_mfma_f32_16x16x32_bf16 v[12:15], v[28:31], v[196:199], v[12:15]
    v_and_b32_dpp v24, v22, v4 row_newbcast:4 row_mask:0xf bank_mask:0xf
    v_and_b32_dpp v25, v22, v5 row_newbcast:4 row_mask:0xf bank_mask:0xf
    v_and_b32_dpp v26, v22, v6 row_newbcast:4 row_mask:0xf bank_mask:0xf
    v_and_b32_dpp v27, v22, v7 row_newbcast:4 row_mask:0xf bank_mask:0xf
    s_waitcnt vmcnt(2)
    buffer_load_dwordx4 v[212:215], v68, s[28:31], 0 offen nt
    v_xor_b32 v68, 0x4200, v2
    s_barrier
    buffer_load_dwordx4 v[72:75], v42, s[36:39], s17 offen offset:0 nt
    v_mfma_f32_16x16x32_bf16 v[12:15], v[24:27], v[200:203], v[12:15]
    v_and_b32_dpp v28, v22, v4 row_newbcast:12 row_mask:0xf bank_mask:0xf
    v_and_b32_dpp v29, v22, v5 row_newbcast:12 row_mask:0xf bank_mask:0xf
    v_and_b32_dpp v30, v22, v6 row_newbcast:12 row_mask:0xf bank_mask:0xf
    v_and_b32_dpp v31, v22, v7 row_newbcast:12 row_mask:0xf bank_mask:0xf
    s_waitcnt vmcnt(3)
    buffer_load_dwordx4 v[216:219], v68, s[28:31], 0 offen nt
    v_xor_b32 v68, 0x57600, v2
    s_barrier
    v_mfma_f32_16x16x32_bf16 v[12:15], v[28:31], v[204:207], v[12:15]
    v_and_b32_dpp v24, v23, v4 row_newbcast:0 row_mask:0xf bank_mask:0xf
    v_and_b32_dpp v25, v23, v5 row_newbcast:0 row_mask:0xf bank_mask:0xf
    v_and_b32_dpp v26, v23, v6 row_newbcast:0 row_mask:0xf bank_mask:0xf
    v_and_b32_dpp v27, v23, v7 row_newbcast:0 row_mask:0xf bank_mask:0xf
    s_waitcnt vmcnt(3)
    buffer_load_dwordx4 v[220:223], v68, s[28:31], 0 offen nt
    s_barrier
    buffer_load_dwordx4 v[76:79], v42, s[36:39], s17 offen offset:1280 nt
    v_mfma_f32_16x16x32_bf16 v[12:15], v[24:27], v[208:211], v[12:15]
    v_and_b32_dpp v28, v23, v4 row_newbcast:8 row_mask:0xf bank_mask:0xf
    v_and_b32_dpp v29, v23, v5 row_newbcast:8 row_mask:0xf bank_mask:0xf
    v_and_b32_dpp v30, v23, v6 row_newbcast:8 row_mask:0xf bank_mask:0xf
    v_and_b32_dpp v31, v23, v7 row_newbcast:8 row_mask:0xf bank_mask:0xf
    s_waitcnt vmcnt(4)
    buffer_load_dwordx4 v[80:83], v42, s[36:39], s17 offen offset:2560 nt
    v_mfma_f32_16x16x32_bf16 v[12:15], v[28:31], v[212:215], v[12:15]
    v_and_b32_dpp v24, v23, v4 row_newbcast:4 row_mask:0xf bank_mask:0xf
    v_and_b32_dpp v25, v23, v5 row_newbcast:4 row_mask:0xf bank_mask:0xf
    v_and_b32_dpp v26, v23, v6 row_newbcast:4 row_mask:0xf bank_mask:0xf
    v_and_b32_dpp v27, v23, v7 row_newbcast:4 row_mask:0xf bank_mask:0xf
    s_waitcnt vmcnt(3)
    buffer_load_dwordx4 v[84:87], v42, s[36:39], s17 offen offset:3840 nt
    v_mfma_f32_16x16x32_bf16 v[12:15], v[24:27], v[216:219], v[12:15]
    v_and_b32_dpp v28, v23, v4 row_newbcast:12 row_mask:0xf bank_mask:0xf
    v_and_b32_dpp v29, v23, v5 row_newbcast:12 row_mask:0xf bank_mask:0xf
    v_and_b32_dpp v30, v23, v6 row_newbcast:12 row_mask:0xf bank_mask:0xf
    v_and_b32_dpp v31, v23, v7 row_newbcast:12 row_mask:0xf bank_mask:0xf
    s_waitcnt vmcnt(3)
    s_nop 0
    v_mfma_f32_16x16x32_bf16 v[12:15], v[28:31], v[220:223], v[12:15]
    s_mov_b32 exec_hi, 0
    s_cmp_eq_u64 s[100:101], 0
    s_nop 5
    ds_write_b128 v50, v[12:15] offset:0
    s_mov_b64 exec, -1
    s_waitcnt lgkmcnt(0)
    s_barrier
    ds_read_b128 v[16:19], v51 offset:0
    s_waitcnt lgkmcnt(0)
    v_add_f32_dpp v45, v16, v16 row_ror:8 row_mask:0xf bank_mask:0x3
    v_add_f32_dpp v45, v17, v17 row_ror:8 row_mask:0xf bank_mask:0xc
    v_add_f32_dpp v46, v18, v18 row_ror:8 row_mask:0xf bank_mask:0x3
    v_add_f32_dpp v46, v19, v19 row_ror:8 row_mask:0xf bank_mask:0xc
    v_add_f32_dpp v20, v45, v45 row_shl:4 row_mask:0xf bank_mask:0x5
    s_nop 0
    v_add_f32_dpp v20, v46, v46 row_shr:4 row_mask:0xf bank_mask:0xa
    s_nop 1
    v_add_f32_dpp v20, v20, v20 quad_perm:[1,0,3,2] row_mask:0xf bank_mask:0xf
    s_mov_b64 exec, s[4:5]
    v_bfi_b32 v20, v61, v57, v20
    s_cbranch_scc0 L_o_far
    buffer_store_dword v20, v52, s[44:47], 0 offen
L_o_sent:
    s_mov_b64 exec, -1
    s_cmp_ge_u32 s16, 5
    s_cbranch_scc1 L_not_proj
L_o_poll:
    buffer_load_dwordx2 v[144:145], v53, s[44:47], 0 offen sc1
    s_waitcnt vmcnt(0)
    v_xor_b32 v144, s54, v144
    v_xor_b32 v145, v67, v145
    v_bitop3_b32 v45, v144, v145, v61 bitop3:0xa8
    v_add_f32_dpp v112, v144, v144 quad_perm:[1,0,3,2] row_mask:0xf bank_mask:0xf
    v_cmp_ne_u32 vcc, 0, v45
    v_add_f32_dpp v113, v145, v145 quad_perm:[1,0,3,2] row_mask:0xf bank_mask:0xf
    s_cbranch_vccnz L_o_retry
L_o_ok:
    v_add_f32_dpp v112, v112, v112 quad_perm:[2,3,0,1] row_mask:0xf bank_mask:0xf
    v_add_f32_dpp v113, v113, v113 quad_perm:[2,3,0,1] row_mask:0xf bank_mask:0xf
    v_cvt_pk_bf16_f32 v112, v112, v112
    v_cvt_pk_bf16_f32 v113, v113, v113
    v_and_b32 v116, v112, v4
    v_and_b32 v117, v112, v5
    v_and_b32_dpp v118, v112, v6 row_ror:4 row_mask:0xf bank_mask:0xf
    v_and_b32_dpp v119, v112, v7 row_ror:4 row_mask:0xf bank_mask:0xf
    v_and_b32 v120, v113, v4
    v_and_b32 v121, v113, v5
    v_mfma_f32_16x16x32_bf16 v[12:15], v[116:119], v[72:75], 0
    v_and_b32_dpp v122, v113, v6 row_ror:4 row_mask:0xf bank_mask:0xf
    v_and_b32_dpp v123, v113, v7 row_ror:4 row_mask:0xf bank_mask:0xf
    v_and_b32_dpp v124, v112, v4 row_ror:12 row_mask:0xf bank_mask:0xf
    v_and_b32_dpp v125, v112, v5 row_ror:12 row_mask:0xf bank_mask:0xf
    v_mfma_f32_16x16x32_bf16 v[12:15], v[120:123], v[76:79], v[12:15]
    v_and_b32 v126, v112, v6
    v_and_b32 v127, v112, v7
    v_and_b32_dpp v128, v113, v4 row_ror:12 row_mask:0xf bank_mask:0xf
    v_and_b32_dpp v129, v113, v5 row_ror:12 row_mask:0xf bank_mask:0xf
    v_mfma_f32_16x16x32_bf16 v[12:15], v[124:127], v[80:83], v[12:15]
    v_and_b32 v130, v113, v6
    v_and_b32 v131, v113, v7
    s_nop 1
    v_mfma_f32_16x16x32_bf16 v[12:15], v[128:131], v[84:87], v[12:15]
    s_nop 7
    ds_write_b128 v62, v[12:15] offset:4352
    s_waitcnt lgkmcnt(0)
    s_barrier
    ds_read_b128 v[112:115], v63 offset:4352
    s_waitcnt lgkmcnt(0)
    v_add_f32_dpp v45, v112, v112 row_ror:8 row_mask:0xf bank_mask:0x3
    v_add_f32_dpp v45, v113, v113 row_ror:8 row_mask:0xf bank_mask:0xc
    v_add_f32_dpp v46, v114, v114 row_ror:8 row_mask:0xf bank_mask:0x3
    v_add_f32_dpp v46, v115, v115 row_ror:8 row_mask:0xf bank_mask:0xc
    v_add_f32_dpp v116, v45, v45 row_shl:4 row_mask:0xf bank_mask:0x5
    s_nop 0
    v_add_f32_dpp v116, v46, v46 row_shr:4 row_mask:0xf bank_mask:0xa
    s_nop 1
    v_add_f32_dpp v116, v116, v116 quad_perm:[1,0,3,2] row_mask:0xf bank_mask:0xf
L_acc:
    v_cndmask_b32 v117, v116, 1.0, s[64:65]
    buffer_atomic_add_f32 v117, v54, s[44:47], s18 offen sc0
    s_add_u32 s10, s99, 31
    s_mov_b64 s[6:7], exec
    s_waitcnt vmcnt(0)
    v_cmp_eq_u32 vcc, s10, v117
    v_add_f32 v46, v117, v116
    s_and_b64 vcc, vcc, s[64:65]
    v_cvt_pk_bf16_f32 v46, v46, v46
    s_lshr_b64 exec, vcc, 1
    s_cbranch_scc0 L_acc_done
    buffer_store_short v46, v58, s[48:51], s17 offen
L_acc_done:
    s_mov_b64 exec, s[6:7]
    v_subrev_u32 v45, s99, v117
    v_cmp_lt_u32 s[8:9], 31, v45
    s_nop 0
    s_and_b64 exec, s[8:9], s[64:65]
    s_cbranch_execnz L_acc_early
    s_endpgm
L_acc_early:
    buffer_load_dword v117, v54, s[44:47], s18 offen sc1
    s_waitcnt vmcnt(0)
    v_subrev_u32 v45, s99, v117
    v_cmp_lt_u32 vcc, 31, v45
    s_sub_u32 s58, s58, 1
    s_cbranch_scc1 L_end
    s_cbranch_vccnz L_acc_early
    s_lshr_b64 s[8:9], exec, 1
    s_or_b64 exec, exec, s[8:9]
    s_branch L_acc
L_o_retry:
    s_sub_u32 s58, s58, 1
    s_cbranch_scc0 L_o_poll
    s_mov_b32 s58, 0
    s_branch L_o_ok
L_o_far:
    buffer_store_dword v20, v52, s[44:47], 0 offen sc1
    s_branch L_o_sent
L_ml_retry:
    s_sub_u32 s58, s58, 1
    s_cmov_b32 s58, 0
    s_cbranch_scc1 L_ml_ok
    buffer_load_dwordx4 v[36:39], v56, s[44:47], 0 offen sc1
    s_waitcnt vmcnt(0)
    s_branch L_ml_check
L_q_retry:
    s_sub_u32 s58, s58, 1
    s_cmov_b32 s58, 0
    s_cbranch_scc1 L_q_ok
    buffer_load_dwordx4 v[80:83], v49, s[44:47], 0 offen sc1
    s_waitcnt vmcnt(0)
    s_branch L_q_check
L_not_proj:
    s_lshl3_add_u32 s59, s21, s16
    s_lshl3_add_u32 s59, s59, s20
    s_cmp_lg_u32 s59, 0x28
    s_cbranch_scc1 L_fin
    v_lshrrev_b32 v45, 3, v1
    v_and_b32 v46, 7, v1
    v_lshl_add_u32 v46, v45, 6, v46
    v_lshlrev_b32 v46, 7, v46
L_ep_poll:
    s_mov_b32 s4, 65536
    buffer_load_dwordx4 v[112:115], v46, s[44:47], s4 offen sc1
    s_mov_b32 s4, 131072
    buffer_load_dwordx4 v[116:119], v46, s[44:47], s4 offen sc1
    s_mov_b32 s4, 196608
    buffer_load_dwordx4 v[120:123], v46, s[44:47], s4 offen sc1
    s_mov_b32 s4, 262144
    buffer_load_dwordx4 v[124:127], v46, s[44:47], s4 offen sc1
    s_waitcnt vmcnt(0)
    v_xor_b32 v112, s54, v112
    v_xor_b32 v113, s55, v113
    v_xor_b32 v114, s54, v114
    v_xor_b32 v115, s56, v115
    v_xor_b32 v116, s54, v116
    v_xor_b32 v117, s55, v117
    v_xor_b32 v118, s54, v118
    v_xor_b32 v119, s56, v119
    v_xor_b32 v120, s54, v120
    v_xor_b32 v121, s55, v121
    v_xor_b32 v122, s54, v122
    v_xor_b32 v123, s56, v123
    v_xor_b32 v124, s54, v124
    v_xor_b32 v125, s55, v125
    v_xor_b32 v126, s54, v126
    v_xor_b32 v127, s56, v127
    v_or3_b32 v45, v112, v113, v114
    v_or3_b32 v45, v45, v115, v116
    v_or3_b32 v45, v45, v117, v118
    v_or3_b32 v45, v45, v119, v120
    v_or3_b32 v45, v45, v121, v122
    v_or3_b32 v45, v45, v123, v124
    v_or3_b32 v45, v45, v125, v126
    v_bitop3_b32 v45, v45, v127, v61 bitop3:0xa8
    v_cmp_ne_u32 vcc, 0, v45
    s_cbranch_vccz L_ep_ok
    s_sub_u32 s58, s58, 1
    s_cbranch_scc0 L_ep_poll
L_ep_ok:
    v_mov_b32 v45, s53
    s_mov_b64 exec, 1
    buffer_store_dword v45, v1, s[44:47], 0 offen sc1
    s_mov_b64 exec, -1
L_fin:
L_end:
    s_waitcnt lgkmcnt(0)
    s_endpgm
.section .rodata,"a"
.p2align 6
.amdhsa_kernel standalone__sliding_block_cached__decode_kernel
  .amdhsa_next_free_vgpr 256
  .amdhsa_next_free_sgpr 102
  .amdhsa_accum_offset 256
  .amdhsa_group_segment_fixed_size 0
  .amdhsa_kernarg_size 64
  .amdhsa_user_sgpr_count 2
  .amdhsa_user_sgpr_kernarg_segment_ptr 1
  .amdhsa_system_sgpr_workgroup_id_x 1
  .amdhsa_float_denorm_mode_32 3
.end_amdhsa_kernel
```
